```python
import torch

def _softmax(x, axis=-1):
    return torch.softmax(x, dim=axis)
def _gelu(x):
    return torch.nn.functional.gelu(x, approximate="tanh")
def _silu(x):
    return torch.nn.functional.silu(x)
def _sigmoid(x):
    return torch.sigmoid(x)
def _layernorm(x, axis=-1, eps=1e-5):
    m = x.mean(dim=axis, keepdim=True)
    v = x.var(dim=axis, keepdim=True, unbiased=False)
    return (x - m) / torch.sqrt(v + eps)
def _scatter_add(tgt, idx, src, axis=0):
    return tgt.clone().index_add_(axis, idx, src)
def _segment_sum(src, seg, n):
    out = torch.zeros((n,) + src.shape[1:], dtype=src.dtype)
    return out.index_add_(0, seg, src)
def _pad(x, pw):
    flat = tuple(v for pair in reversed(pw) for v in pair)
    return torch.nn.functional.pad(x, flat)

kernel_name = 'recurrent_scan__sliding_block_cached__dense_activation_squared_relu__decode'

def setup_inputs():

    _w = (lambda a: (lambda t: t.to(torch.bfloat16) if t.is_floating_point() else t)(torch.as_tensor(a)))
    def _A_setup():
        B, Sq, D = 1, 1, 640
        Hq, Hkv, Sk, Dh = 32, 32, 32768, 192
        assert Hq % Hkv == 0, (Hq, Hkv)
        return {
            "x": _w((lambda *s: torch.randn(*s, dtype=torch.bfloat16) * 0.05)(B, Sq, D)),
            "k_cache": _w((lambda *s: torch.randn(*s, dtype=torch.bfloat16) * 0.8)(B, Hkv, Sk, Dh)),
            "v_cache": _w((lambda *s: torch.randn(*s, dtype=torch.bfloat16) * 0.2)(B, Hkv, Sk, Dh)),
            "wq": _w((lambda *s: torch.randn(*s, dtype=torch.bfloat16) * 0.8)(D, Hq * Dh) * (D ** -0.5)),
            "wo": _w((lambda *s: torch.randn(*s, dtype=torch.bfloat16) * 0.2)(Hq * Dh, D) * ((Hq * Dh) ** -0.5)),
        }
    _A_in = _A_setup()

    def _B_setup():
        B, S, D, F = 1, 1, 640, 1536
        return {
            "x": _w((lambda *s: torch.randn(*s, dtype=torch.bfloat16) * 0.05)(B, S, D)),
            "w1": _w((lambda *s: torch.randn(*s, dtype=torch.bfloat16) * 0.1)(D, F)),
            "b1": _w((lambda *s: torch.randn(*s, dtype=torch.bfloat16) * 0.1)(F)),
            "w2": _w((lambda *s: torch.randn(*s, dtype=torch.bfloat16) * 0.1)(F, D)),
            "b2": _w((lambda *s: torch.randn(*s, dtype=torch.bfloat16) * 0.1)(D)),
        }
    _B_in = _B_setup()

    return {
        "A_x": _A_in["x"],
        "A_k_cache": _A_in["k_cache"],
        "A_v_cache": _A_in["v_cache"],
        "A_wq": _A_in["wq"],
        "A_wo": _A_in["wo"],
        "B_x": _B_in["x"],
        "B_w1": _B_in["w1"],
        "B_b1": _B_in["b1"],
        "B_w2": _B_in["w2"],
        "B_b2": _B_in["b2"],
    }

def reference(A_x, A_k_cache, A_v_cache, A_wq, A_wo, B_x, B_w1, B_b1, B_w2, B_b2):
    def _A_ref(x, k_cache, v_cache, wq, wo):
        B, Sq, D = x.shape
        Hq, Dh = 32, 192
        Hkv, Sk = k_cache.shape[1], k_cache.shape[2]
        W = min(4096, max(256, Sk // 4))
        rep = Hq // Hkv
        q = (lambda x, *d: x.permute(*d))((x @ wq).reshape(B, Sq, Hq, Dh), 0, 2, 1, 3)
        k = (lambda x, n, axis: torch.repeat_interleave(x, n, dim=axis))(k_cache[:, :, Sk - W:, :], rep, axis=1)
        v = (lambda x, n, axis: torch.repeat_interleave(x, n, dim=axis))(v_cache[:, :, Sk - W:, :], rep, axis=1)
        scores = torch.einsum("bhqd,bhkd->bhqk", q, k) * (Dh ** -0.5)
        p = _softmax(scores, axis=-1)
        o = torch.einsum("bhqk,bhkd->bhqd", p, v)
        return (lambda x, *d: x.permute(*d))(o, 0, 2, 1, 3).reshape(B, Sq, Hq * Dh) @ wo

    def _B_ref(x, w1, b1, w2, b2):
        h = torch.einsum("bsd,df->bsf", x, w1) + b1
        zero = torch.zeros_like(h)
        r = torch.where(h > zero, h, zero)
        h = r * r
        out = torch.einsum("bsf,fd->bsd", h, w2) + b2
        return out

    x = A_x
    xn = _layernorm(x, axis=-1)
    s = _A_ref(xn, A_k_cache, A_v_cache, A_wq, A_wo)
    g = _silu(_B_ref(xn, B_w1, B_b1, B_w2, B_b2))
    return x + s * g
```

```asm
; @launch grid=(256,1,1) block=(512,1,1) lds=17472
.amdgcn_target "amdgcn-amd-amdhsa--gfx950"
.text
.globl recurrent_scan__sliding_block_cached__dense_activation_squared_relu__decode_kernel
.p2align 8
.type recurrent_scan__sliding_block_cached__dense_activation_squared_relu__decode_kernel,@function
recurrent_scan__sliding_block_cached__dense_activation_squared_relu__decode_kernel:
    s_cmp_ge_u32 s2, 256
    s_cbranch_scc1 L_end
    s_load_dwordx16 s[4:19], s[0:1], 0
    s_load_dwordx8 s[20:27], s[0:1], 64
    s_load_dwordx2 s[28:29], s[0:1], 96
    v_and_b32 v1, 63, v0
    v_lshrrev_b32 v7, 6, v0
    v_lshrrev_b32 v2, 3, v1
    v_and_b32 v3, 7, v1
    v_readfirstlane_b32 s3, v7
    v_mul_u32_u24 v4, 384, v2
    v_lshl_add_u32 v4, v3, 4, v4
    s_and_b32 s30, s2, 31
    s_lshr_b32 s31, s2, 5
    s_and_b32 s68, s2, 7
    s_lshl_b32 s68, s68, 2
    s_lshr_b32 s69, s30, 3
    s_add_u32 s68, s68, s69
    s_mul_i32 s67, s68, 12582912
    s_lshr_b32 s68, s3, 2
    s_mul_i32 s68, s68, 256
    s_mul_i32 s69, s31, 4
    s_add_u32 s68, s68, s69
    s_and_b32 s69, s3, 3
    s_mul_i32 s69, s69, 1
    s_add_u32 s68, s68, s69
    s_mul_i32 s68, s68, 3072
    s_add_u32 s67, s67, s68
    s_add_u32 s67, s67, 11010048
    s_mov_b32 s34, 691200
    s_mov_b32 s35, 0x20000
    s_cmp_lt_u32 s3, 4
    s_cbranch_scc1 L_nocpf
    s_getpc_b64 s[72:73]
L_pc:
    s_lshr_b32 s68, s2, 1
    s_and_b32 s68, s68, 12
    s_add_u32 s68, s68, s3
    s_sub_u32 s68, s68, 4
    s_lshl_b32 s68, s68, 10
    v_lshl_add_u32 v12, v1, 4, s68
    v_min_u32 v12, L_codeend-L_pc-16, v12
    v_mov_b32 v13, s73
    v_add_co_u32 v12, vcc, s72, v12
    s_nop 1
    v_addc_co_u32 v13, vcc, 0, v13, vcc
    global_load_dwordx4 v[232:235], v[12:13], off
    s_nop 3
L_nocpf:
    s_waitcnt lgkmcnt(0)
    s_add_u32 s32, s6, s67
    s_addc_u32 s33, s7, 0
    s_cmp_lt_u32 s3, 4
    s_cbranch_scc0 L_nofast
    s_mov_b32 s70, 0
    buffer_load_dwordx4 v[64:67], v4, s[32:35], s70 offen offset:0 nt
    buffer_load_dwordx4 v[68:71], v4, s[32:35], s70 offen offset:128 nt
    buffer_load_dwordx4 v[72:75], v4, s[32:35], s70 offen offset:256 nt
    s_mov_b32 s70, 98304
    buffer_load_dwordx4 v[76:79], v4, s[32:35], s70 offen offset:0 nt
    buffer_load_dwordx4 v[80:83], v4, s[32:35], s70 offen offset:128 nt
    buffer_load_dwordx4 v[84:87], v4, s[32:35], s70 offen offset:256 nt
L_nofast:
    v_and_b32 v12, 15, v1
    v_lshlrev_b32 v12, 2, v12
    v_mov_b32 v13, 0
    ds_write_b32 v12, v13 offset:7040
    v_mov_b32 v14, 7040
    s_add_u32 s0, s28, 2459648
    s_addc_u32 s1, s29, 0
    s_and_b32 s74, s2, 7
    s_lshr_b32 s75, s2, 3
    s_mul_i32 s64, s75, 205
    s_lshr_b32 s64, s64, 11
    s_mul_i32 s65, s64, 10
    s_sub_u32 s65, s75, s65
    s_mul_i32 s66, s2, 5760
    s_mov_b64 s[78:79], -1
    v_and_b32 v12, 1, v3
    v_lshlrev_b32 v12, 4, v12
    v_mov_b32 v13, 0xffff
    v_lshlrev_b32 v12, v12, v13
    v_lshrrev_b32 v13, 1, v3
    v_cmp_eq_u32 vcc, 0, v13
    s_nop 1
    v_cndmask_b32 v8, 0, v12, vcc
    v_cmp_eq_u32 vcc, 1, v13
    s_nop 1
    v_cndmask_b32 v9, 0, v12, vcc
    v_cmp_eq_u32 vcc, 2, v13
    s_nop 1
    v_cndmask_b32 v10, 0, v12, vcc
    v_cmp_eq_u32 vcc, 3, v13
    s_nop 1
    v_cndmask_b32 v11, 0, v12, vcc
    v_lshlrev_b32 v5, 5, v3
    v_bfe_u32 v12, v1, 4, 1
    v_lshl_add_u32 v5, v12, 4, v5
    v_bfe_u32 v12, v1, 3, 1
    v_lshl_add_u32 v5, v12, 3, v5
    v_bfe_u32 v12, v1, 5, 1
    v_lshl_add_u32 v5, v12, 2, v5
    v_mul_u32_u24 v6, 5120, v2
    v_lshl_add_u32 v6, v3, 4, v6
    v_mul_u32_u24 v7, 1280, v2
    v_lshl_add_u32 v7, v3, 4, v7
    s_and_b32 s68, s3, 3
    s_lshl_b32 s68, s68, 3
    s_add_u32 s68, s68, 7056
    v_mov_b32 v55, s68
    v_mov_b32 v54, 1
    s_lshl_b32 s68, s64, 3
    s_add_u32 s68, s68, s3
    s_mul_i32 s69, s68, 171
    s_lshr_b32 s69, s69, 10
    s_mul_i32 s70, s69, 6
    s_sub_u32 s73, s68, s70
    s_lshl_b32 s77, s69, 3
    s_add_u32 s77, s77, s74
    s_lshl_b32 s70, s74, 2
    s_add_u32 s69, s69, s70
    s_mul_i32 s69, s69, 245760
    s_mul_i32 s70, s73, 40960
    s_add_u32 s69, s69, s70
    s_lshl_b32 s72, s65, 7
    s_add_u32 s69, s69, s72
    s_mul_i32 s70, s74, 24
    s_add_u32 s70, s70, s68
    s_mul_i32 s70, s70, 10240
    s_add_u32 s70, s70, s72
    s_cmp_lt_u32 s75, 30
    s_cselect_b32 s69, s69, 0
    s_cselect_b32 s70, s70, 0
    s_add_u32 s36, s8, s67
    s_addc_u32 s37, s9, 0
    s_mov_b32 s38, 691200
    s_mov_b32 s39, 0x20000
    s_waitcnt lgkmcnt(0)
    s_load_dword s76, s[0:1], 0
    s_mov_b32 s48, s28
    s_mov_b32 s49, s29
    s_mov_b32 s50, 2459776
    s_mov_b32 s51, 0x20000
    s_mov_b32 s44, s4
    s_mov_b32 s45, s5
    s_mov_b32 s46, 1280
    s_mov_b32 s47, 0x20000
    s_add_u32 s56, s12, s69
    s_addc_u32 s57, s13, 0
    s_mov_b32 s58, 0
    s_mov_b32 s59, 0x20000
    s_add_u32 s52, s20, s70
    s_addc_u32 s53, s21, 0
    s_mov_b32 s54, 0
    s_mov_b32 s55, 0x20000
    s_barrier
    s_cmp_lt_u32 s3, 4
    s_cbranch_scc1 L_bulk6
    s_cmp_lt_u32 s75, 30
    s_cbranch_scc1 L_phaseA1
    s_waitcnt lgkmcnt(0)
    s_add_u32 s76, s76, 0x9e3779b9
    s_branch L_pubdone
L_phaseA1:
    s_setprio 3
    v_lshlrev_b32 v12, 2, v1
    buffer_load_dword v32, v12, s[44:47], 0 offen offset:0
    buffer_load_dword v33, v12, s[44:47], 0 offen offset:256
    buffer_load_dword v34, v12, s[44:47], 0 offen offset:512
    buffer_load_dword v35, v12, s[44:47], 0 offen offset:768
    buffer_load_dword v36, v12, s[44:47], 0 offen offset:1024
    s_lshl_b32 s68, s75, 2
    s_add_u32 s68, s68, s3
    s_sub_u32 s68, s68, 4
    s_mul_i32 s69, s68, 137
    s_lshr_b32 s69, s69, 11
    s_mul_i32 s70, s69, 15
    s_sub_u32 s68, s68, s70
    s_mul_i32 s15, s74, 15
    s_add_u32 s15, s15, s68
    s_lshl_b32 s15, s15, 3
    s_add_u32 s15, s15, s69
    s_lshl_b32 s15, s15, 9
    s_add_u32 s15, s15, 1476608
    s_mul_i32 s71, s69, 160
    s_mul_i32 s69, s69, 80
    s_mul_i32 s70, s74, 12
    s_add_u32 s70, s70, s68
    s_mul_i32 s72, s74, 3
    s_add_u32 s72, s72, s68
    s_sub_u32 s72, s72, 12
    s_cmp_ge_u32 s68, 12
    s_cselect_b32 s68, s72, s70
    s_cselect_b32 s40, s16, s10
    s_cselect_b32 s41, s17, s11
    s_mov_b32 s67, 12288
    s_cmov_b32 s67, 3072
    s_lshl_b32 s68, s68, 7
    s_mul_i32 s69, s69, s67
    s_add_u32 s68, s68, s69
    s_mul_i32 s42, s67, 79
    s_add_u32 s42, s42, 128
    s_mul_i32 s70, s67, 10
    v_mul_u32_u24 v12, 20, v2
    v_mul_u32_u24 v13, s70, v2
    v_lshl_add_u32 v13, v3, 4, v13
    s_add_u32 s40, s40, s68
    s_addc_u32 s41, s41, 0
    s_mov_b32 s43, 0x20000
    buffer_load_dwordx4 v[16:19], v12, s[44:47], s71 offen
    buffer_load_dword v20, v12, s[44:47], s71 offen offset:16
    s_mov_b32 s70, 0
    buffer_load_dwordx4 v[64:67], v13, s[40:43], s70 offen nt
    s_add_u32 s70, s70, s67
    buffer_load_dwordx4 v[68:71], v13, s[40:43], s70 offen nt
    s_add_u32 s70, s70, s67
    buffer_load_dwordx4 v[72:75], v13, s[40:43], s70 offen nt
    s_add_u32 s70, s70, s67
    buffer_load_dwordx4 v[76:79], v13, s[40:43], s70 offen nt
    s_add_u32 s70, s70, s67
    buffer_load_dwordx4 v[80:83], v13, s[40:43], s70 offen nt
    s_add_u32 s70, s70, s67
    buffer_load_dwordx4 v[84:87], v13, s[40:43], s70 offen nt
    s_add_u32 s70, s70, s67
    buffer_load_dwordx4 v[88:91], v13, s[40:43], s70 offen nt
    s_add_u32 s70, s70, s67
    buffer_load_dwordx4 v[92:95], v13, s[40:43], s70 offen nt
    s_add_u32 s70, s70, s67
    buffer_load_dwordx4 v[96:99], v13, s[40:43], s70 offen nt
    s_add_u32 s70, s70, s67
    buffer_load_dwordx4 v[100:103], v13, s[40:43], s70 offen nt
    s_waitcnt vmcnt(10) lgkmcnt(0)
    s_add_u32 s76, s76, 0x9e3779b9
    v_lshlrev_b32 v200, 16, v32
    v_and_b32 v201, 0xffff0000, v32
    v_lshlrev_b32 v202, 16, v33
    v_and_b32 v203, 0xffff0000, v33
    v_lshlrev_b32 v204, 16, v34
    v_and_b32 v205, 0xffff0000, v34
    v_lshlrev_b32 v206, 16, v35
    v_and_b32 v207, 0xffff0000, v35
    v_lshlrev_b32 v208, 16, v36
    v_and_b32 v209, 0xffff0000, v36
    v_add_f32 v37, v200, v201
    v_add_f32 v38, v202, v203
    v_add_f32 v39, v204, v205
    v_add_f32 v40, v206, v207
    v_add_f32 v41, v208, v209
    v_add_f32 v37, v37, v38
    v_add_f32 v39, v39, v40
    v_add_f32 v37, v37, v41
    v_add_f32 v37, v37, v39
    s_nop 1
    v_add_f32_dpp v37, v37, v37 quad_perm:[1,0,3,2] row_mask:0xf bank_mask:0xf
    s_nop 1
    v_add_f32_dpp v37, v37, v37 quad_perm:[2,3,0,1] row_mask:0xf bank_mask:0xf
    s_nop 1
    v_add_f32_dpp v37, v37, v37 row_half_mirror row_mask:0xf bank_mask:0xf
    s_nop 1
    v_add_f32_dpp v37, v37, v37 row_ror:8 row_mask:0xf bank_mask:0xf
    v_mov_b32 v38, v37
    s_nop 1
    v_permlane16_swap_b32 v37, v38
    v_add_f32 v37, v37, v38
    v_mov_b32 v38, v37
    s_nop 1
    v_permlane32_swap_b32 v37, v38
    v_add_f32 v37, v37, v38
    v_mul_f32 v37, 0x3acccccd, v37
    v_sub_f32 v200, v200, v37
    v_sub_f32 v201, v201, v37
    v_sub_f32 v202, v202, v37
    v_sub_f32 v203, v203, v37
    v_sub_f32 v204, v204, v37
    v_sub_f32 v205, v205, v37
    v_sub_f32 v206, v206, v37
    v_sub_f32 v207, v207, v37
    v_sub_f32 v208, v208, v37
    v_sub_f32 v209, v209, v37
    v_mul_f32 v38, v200, v200
    v_mul_f32 v39, v201, v201
    v_fmac_f32 v38, v202, v202
    v_fmac_f32 v39, v203, v203
    v_fmac_f32 v38, v204, v204
    v_fmac_f32 v39, v205, v205
    v_fmac_f32 v38, v206, v206
    v_fmac_f32 v39, v207, v207
    v_fmac_f32 v38, v208, v208
    v_fmac_f32 v39, v209, v209
    v_add_f32 v38, v38, v39
    s_nop 1
    v_add_f32_dpp v38, v38, v38 quad_perm:[1,0,3,2] row_mask:0xf bank_mask:0xf
    s_nop 1
    v_add_f32_dpp v38, v38, v38 quad_perm:[2,3,0,1] row_mask:0xf bank_mask:0xf
    s_nop 1
    v_add_f32_dpp v38, v38, v38 row_half_mirror row_mask:0xf bank_mask:0xf
    s_nop 1
    v_add_f32_dpp v38, v38, v38 row_ror:8 row_mask:0xf bank_mask:0xf
    v_mov_b32 v39, v38
    s_nop 1
    v_permlane16_swap_b32 v38, v39
    v_add_f32 v38, v38, v39
    v_mov_b32 v39, v38
    s_nop 1
    v_permlane32_swap_b32 v38, v39
    v_add_f32 v38, v38, v39
    v_mul_f32 v38, 0x3acccccd, v38
    v_cvt_pk_bf16_f32 v37, v37, v37
    v_and_b32 v37, 0xffff0000, v37
    v_cvt_pk_bf16_f32 v38, v38, v38
    v_and_b32 v38, 0xffff0000, v38
    v_add_f32 v38, 0x3727c5ac, v38
    v_cvt_pk_bf16_f32 v38, v38, v38
    v_and_b32 v38, 0xffff0000, v38
    v_sqrt_f32 v38, v38
    s_nop 0
    v_cvt_pk_bf16_f32 v38, v38, v38
    v_and_b32 v38, 0xffff0000, v38
    v_rcp_f32 v39, v38
    v_lshlrev_b32 v200, 16, v16
    v_and_b32 v201, 0xffff0000, v16
    v_lshlrev_b32 v202, 16, v17
    v_and_b32 v203, 0xffff0000, v17
    v_lshlrev_b32 v204, 16, v18
    v_and_b32 v205, 0xffff0000, v18
    v_lshlrev_b32 v206, 16, v19
    v_and_b32 v207, 0xffff0000, v19
    v_lshlrev_b32 v208, 16, v20
    v_and_b32 v209, 0xffff0000, v20
    v_sub_f32 v200, v200, v37
    v_sub_f32 v201, v201, v37
    v_sub_f32 v202, v202, v37
    v_sub_f32 v203, v203, v37
    v_sub_f32 v204, v204, v37
    v_sub_f32 v205, v205, v37
    v_sub_f32 v206, v206, v37
    v_sub_f32 v207, v207, v37
    v_sub_f32 v208, v208, v37
    v_sub_f32 v209, v209, v37
    v_cvt_pk_bf16_f32 v210, v200, v201
    v_cvt_pk_bf16_f32 v211, v202, v203
    v_cvt_pk_bf16_f32 v212, v204, v205
    v_cvt_pk_bf16_f32 v213, v206, v207
    v_cvt_pk_bf16_f32 v214, v208, v209
    v_lshlrev_b32 v200, 16, v210
    v_and_b32 v201, 0xffff0000, v210
    v_lshlrev_b32 v202, 16, v211
    v_and_b32 v203, 0xffff0000, v211
    v_lshlrev_b32 v204, 16, v212
    v_and_b32 v205, 0xffff0000, v212
    v_lshlrev_b32 v206, 16, v213
    v_and_b32 v207, 0xffff0000, v213
    v_lshlrev_b32 v208, 16, v214
    v_and_b32 v209, 0xffff0000, v214
    v_mul_f32 v220, v200, v39
    v_mul_f32 v221, v201, v39
    v_mul_f32 v222, v202, v39
    v_mul_f32 v223, v203, v39
    v_mul_f32 v224, v204, v39
    v_mul_f32 v225, v205, v39
    v_mul_f32 v226, v206, v39
    v_mul_f32 v227, v207, v39
    v_mul_f32 v228, v208, v39
    v_mul_f32 v229, v209, v39
    v_fma_f32 v200, -v220, v38, v200
    v_fma_f32 v201, -v221, v38, v201
    v_fma_f32 v202, -v222, v38, v202
    v_fma_f32 v203, -v223, v38, v203
    v_fma_f32 v204, -v224, v38, v204
    v_fma_f32 v205, -v225, v38, v205
    v_fma_f32 v206, -v226, v38, v206
    v_fma_f32 v207, -v227, v38, v207
    v_fma_f32 v208, -v228, v38, v208
    v_fma_f32 v209, -v229, v38, v209
    v_fma_f32 v220, v200, v39, v220
    v_fma_f32 v221, v201, v39, v221
    v_fma_f32 v222, v202, v39, v222
    v_fma_f32 v223, v203, v39, v223
    v_fma_f32 v224, v204, v39, v224
    v_fma_f32 v225, v205, v39, v225
    v_fma_f32 v226, v206, v39, v226
    v_fma_f32 v227, v207, v39, v227
    v_fma_f32 v228, v208, v39, v228
    v_fma_f32 v229, v209, v39, v229
    v_mov_b32 v44, 0
    v_mov_b32 v45, 0
    v_mov_b32 v46, 0
    v_mov_b32 v47, 0
    v_mov_b32 v49, s76
    v_cvt_pk_bf16_f32 v40, v220, v220
    v_and_b32 v160, v40, v8
    v_and_b32 v161, v40, v9
    v_and_b32 v162, v40, v10
    v_and_b32 v163, v40, v11
    v_cvt_pk_bf16_f32 v41, v221, v221
    v_and_b32 v164, v41, v8
    v_and_b32 v165, v41, v9
    v_and_b32 v166, v41, v10
    v_and_b32 v167, v41, v11
    v_cvt_pk_bf16_f32 v40, v222, v222
    v_and_b32 v168, v40, v8
    v_and_b32 v169, v40, v9
    v_and_b32 v170, v40, v10
    v_and_b32 v171, v40, v11
    v_cvt_pk_bf16_f32 v41, v223, v223
    v_and_b32 v172, v41, v8
    v_and_b32 v173, v41, v9
    v_and_b32 v174, v41, v10
    v_and_b32 v175, v41, v11
    v_cvt_pk_bf16_f32 v40, v224, v224
    v_and_b32 v176, v40, v8
    v_and_b32 v177, v40, v9
    v_and_b32 v178, v40, v10
    v_and_b32 v179, v40, v11
    v_cvt_pk_bf16_f32 v41, v225, v225
    v_and_b32 v180, v41, v8
    v_and_b32 v181, v41, v9
    v_and_b32 v182, v41, v10
    v_and_b32 v183, v41, v11
    v_cvt_pk_bf16_f32 v40, v226, v226
    v_and_b32 v184, v40, v8
    v_and_b32 v185, v40, v9
    v_and_b32 v186, v40, v10
    v_and_b32 v187, v40, v11
    v_cvt_pk_bf16_f32 v41, v227, v227
    v_and_b32 v188, v41, v8
    v_and_b32 v189, v41, v9
    v_and_b32 v190, v41, v10
    v_and_b32 v191, v41, v11
    v_cvt_pk_bf16_f32 v40, v228, v228
    v_and_b32 v192, v40, v8
    v_and_b32 v193, v40, v9
    v_and_b32 v194, v40, v10
    v_and_b32 v195, v40, v11
    v_cvt_pk_bf16_f32 v41, v229, v229
    v_and_b32 v196, v41, v8
    v_and_b32 v197, v41, v9
    v_and_b32 v198, v41, v10
    v_and_b32 v199, v41, v11
    s_waitcnt vmcnt(9)
    v_mfma_f32_16x16x32_bf16 v[44:47], v[160:163], v[64:67], v[44:47]
    s_waitcnt vmcnt(8)
    v_mfma_f32_16x16x32_bf16 v[44:47], v[164:167], v[68:71], v[44:47]
    s_waitcnt vmcnt(7)
    v_mfma_f32_16x16x32_bf16 v[44:47], v[168:171], v[72:75], v[44:47]
    s_waitcnt vmcnt(6)
    v_mfma_f32_16x16x32_bf16 v[44:47], v[172:175], v[76:79], v[44:47]
    s_waitcnt vmcnt(5)
    v_mfma_f32_16x16x32_bf16 v[44:47], v[176:179], v[80:83], v[44:47]
    s_waitcnt vmcnt(4)
    v_mfma_f32_16x16x32_bf16 v[44:47], v[180:183], v[84:87], v[44:47]
    s_waitcnt vmcnt(3)
    v_mfma_f32_16x16x32_bf16 v[44:47], v[184:187], v[88:91], v[44:47]
    s_waitcnt vmcnt(2)
    v_mfma_f32_16x16x32_bf16 v[44:47], v[188:191], v[92:95], v[44:47]
    s_waitcnt vmcnt(1)
    v_mfma_f32_16x16x32_bf16 v[44:47], v[192:195], v[96:99], v[44:47]
    s_waitcnt vmcnt(0)
    v_mfma_f32_16x16x32_bf16 v[44:47], v[196:199], v[100:103], v[44:47]
    v_lshlrev_b32 v12, 6, v3
    v_bfe_u32 v13, v1, 4, 1
    v_lshl_add_u32 v12, v13, 5, v12
    v_bfe_u32 v13, v1, 5, 1
    v_lshl_add_u32 v12, v13, 4, v12
    v_mov_b32 v51, s76
    s_sub_u32 s68, s3, 4
    s_lshl_b32 s68, s68, 9
    v_add_u32 v13, s68, v12
    v_permlane32_swap_b32 v44, v46
    v_permlane32_swap_b32 v45, v47
    s_nop 0
    v_add_f32_dpp v48, v46, v44 row_ror:8 row_mask:0xf bank_mask:0x3
    v_add_f32_dpp v50, v47, v45 row_ror:8 row_mask:0xf bank_mask:0x3
    s_mov_b32 exec_lo, 0x00ff00ff
    s_mov_b32 exec_hi, 0x00ff00ff
    buffer_store_dwordx4 v[48:51], v12, s[48:51], s15 offen
    ds_write_b128 v13, v[48:51] offset:7232
    s_mov_b64 exec, -1
L_pubdone:
    s_cmp_eq_u32 s3, 5
    s_cbranch_scc0 L_noann
    s_getreg_b32 s68, hwreg(HW_REG_XCC_ID)
    v_mov_b32 v12, s68
    v_mov_b32 v13, s76
    s_lshl_b32 s68, s74, 5
    s_add_u32 s68, s68, s75
    s_lshl_b32 s68, s68, 3
    s_add_u32 s68, s68, 1474560
    s_mov_b64 exec, 1
    buffer_store_dwordx2 v[12:13], v2, s[48:51], s68 offen
    s_mov_b64 exec, -1
L_noann:
    s_setprio 0
    s_cmp_lt_u32 s75, 30
    s_cselect_b32 s58, 39808, 0
    s_cselect_b32 s54, 9088, 0
    s_mov_b32 s71, 200000
L_wfa:
    ds_read_b32 v13, v55 offset:0
    s_waitcnt lgkmcnt(0)
    v_readfirstlane_b32 s68, v13
    s_nop 0
    s_cmp_ge_u32 s68, 1
    s_nop 1
    s_cbranch_scc1 L_wfa_d
    s_sleep 1
    s_sub_u32 s71, s71, 1
    s_cbranch_scc0 L_wfa
L_wfa_d:
    v_add_u32 v55, 4, v55
    s_nop 1
L_bulk:
    s_mov_b32 s70, 0
    buffer_load_dwordx4 v[64:67], v4, s[32:35], s70 offen offset:0 nt
    buffer_load_dwordx4 v[68:71], v4, s[32:35], s70 offen offset:128 nt
    buffer_load_dwordx4 v[72:75], v4, s[32:35], s70 offen offset:256 nt
    s_mov_b32 s70, 98304
    buffer_load_dwordx4 v[76:79], v4, s[32:35], s70 offen offset:0 nt
    buffer_load_dwordx4 v[80:83], v4, s[32:35], s70 offen offset:128 nt
    buffer_load_dwordx4 v[84:87], v4, s[32:35], s70 offen offset:256 nt
L_bulk6:
    v_mul_u32_u24 v56, 832, v3
    s_lshl_b32 s68, s3, 7
    v_lshl_add_u32 v57, v2, 4, s68
    v_add_u32 v57, v56, v57
    v_lshlrev_b32 v58, 5, v2
    v_lshl_add_u32 v58, v3, 4, v58
    v_mov_b32 v13, 256
    v_cmp_eq_u32 vcc, 2, v1
    s_nop 1
    v_cndmask_b32 v58, v58, v13, vcc
    s_mul_i32 s68, s3, 384
    s_add_u32 s68, s68, 0
    v_add_u32 v58, s68, v58
    v_mul_u32_u24 v59, 184320, v2
    v_lshl_add_u32 v60, v3, 5, v59
    v_lshrrev_b32 v13, 5, v1
    v_mul_u32_u24 v61, 1280, v13
    v_and_b32 v62, 31, v1
    v_lshl_add_u32 v61, v62, 3, v61
    s_mul_i32 s68, s3, 2560
    v_add_u32 v61, s68, v61
    v_lshlrev_b32 v62, 4, v62
    s_mul_i32 s68, s3, 320
    v_add_u32 v63, s68, v5
    s_mov_b32 s70, 196608
    s_waitcnt vmcnt(5)
    buffer_load_dwordx4 v[88:91], v4, s[32:35], s70 offen offset:0 nt
    s_waitcnt vmcnt(5)
    buffer_load_dwordx4 v[92:95], v4, s[32:35], s70 offen offset:128 nt
    s_waitcnt vmcnt(5)
    buffer_load_dwordx4 v[96:99], v4, s[32:35], s70 offen offset:256 nt
    s_mov_b32 s70, 294912
    s_waitcnt vmcnt(5)
    buffer_load_dwordx4 v[100:103], v4, s[32:35], s70 offen offset:0 nt
    s_waitcnt vmcnt(5)
    buffer_load_dwordx4 v[104:107], v4, s[32:35], s70 offen offset:128 nt
    s_waitcnt vmcnt(5)
    buffer_load_dwordx4 v[108:111], v4, s[32:35], s70 offen offset:256 nt
    s_mov_b32 s70, 393216
    s_waitcnt vmcnt(5)
    buffer_load_dwordx4 v[112:115], v4, s[32:35], s70 offen offset:0 nt
    s_waitcnt vmcnt(5)
    buffer_load_dwordx4 v[116:119], v4, s[32:35], s70 offen offset:128 nt
    s_waitcnt vmcnt(5)
    buffer_load_dwordx4 v[120:123], v4, s[32:35], s70 offen offset:256 nt
    s_mov_b32 s70, 491520
    s_waitcnt vmcnt(5)
    buffer_load_dwordx4 v[124:127], v4, s[32:35], s70 offen offset:0 nt
    s_waitcnt vmcnt(5)
    buffer_load_dwordx4 v[128:131], v4, s[32:35], s70 offen offset:128 nt
    s_waitcnt vmcnt(5)
    buffer_load_dwordx4 v[132:135], v4, s[32:35], s70 offen offset:256 nt
    s_mov_b32 s70, 589824
    s_waitcnt vmcnt(5)
    buffer_load_dwordx4 v[136:139], v4, s[32:35], s70 offen offset:0 nt
    s_waitcnt vmcnt(5)
    buffer_load_dwordx4 v[140:143], v4, s[32:35], s70 offen offset:128 nt
    s_waitcnt vmcnt(5)
    buffer_load_dwordx4 v[144:147], v4, s[32:35], s70 offen offset:256 nt
    s_mov_b32 s70, 688128
    s_waitcnt vmcnt(5)
    buffer_load_dwordx4 v[148:151], v4, s[32:35], s70 offen offset:0 nt
    s_waitcnt vmcnt(5)
    buffer_load_dwordx4 v[152:155], v4, s[32:35], s70 offen offset:128 nt
    s_waitcnt vmcnt(5)
    buffer_load_dwordx4 v[156:159], v4, s[32:35], s70 offen offset:256 nt
    s_mov_b32 s70, 0
    s_waitcnt vmcnt(5)
    buffer_load_dwordx4 v[160:163], v4, s[36:39], s70 offen offset:0 nt
    s_waitcnt vmcnt(5)
    buffer_load_dwordx4 v[164:167], v4, s[36:39], s70 offen offset:128 nt
    s_waitcnt vmcnt(5)
    buffer_load_dwordx4 v[168:171], v4, s[36:39], s70 offen offset:256 nt
    s_mov_b32 s70, 98304
    s_waitcnt vmcnt(5)
    buffer_load_dwordx4 v[172:175], v4, s[36:39], s70 offen offset:0 nt
    s_waitcnt vmcnt(5)
    buffer_load_dwordx4 v[176:179], v4, s[36:39], s70 offen offset:128 nt
    s_waitcnt vmcnt(5)
    buffer_load_dwordx4 v[180:183], v4, s[36:39], s70 offen offset:256 nt
    s_mov_b32 s70, 196608
    s_waitcnt vmcnt(5)
    buffer_load_dwordx4 v[184:187], v4, s[36:39], s70 offen offset:0 nt
    s_waitcnt vmcnt(5)
    buffer_load_dwordx4 v[188:191], v4, s[36:39], s70 offen offset:128 nt
    buffer_load_dwordx4 v[192:195], v4, s[36:39], s70 offen offset:256 nt
    s_mov_b32 s70, 294912
    buffer_load_dwordx4 v[196:199], v4, s[36:39], s70 offen offset:0 nt
    buffer_load_dwordx4 v[200:203], v4, s[36:39], s70 offen offset:128 nt
    buffer_load_dwordx4 v[204:207], v4, s[36:39], s70 offen offset:256 nt
    s_cmp_lt_u32 s3, 4
    s_cbranch_scc1 L_v2
L_qk:
    s_mov_b32 s71, 200000
L_qwait:
    ds_read_b32 v32, v14 offset:0
    s_waitcnt lgkmcnt(0)
    v_readfirstlane_b32 s68, v32
    s_nop 0
    s_cmp_ge_u32 s68, 4
    s_nop 1
    s_cbranch_scc1 L_qwait_d
    s_sleep 2
    s_sub_u32 s71, s71, 1
    s_cbranch_scc0 L_qwait
L_qwait_d:
    v_lshlrev_b32 v12, 4, v3
    ds_read_b128 v[32:35], v12 offset:6656
    ds_read_b128 v[36:39], v12 offset:6784
    ds_read_b128 v[40:43], v12 offset:6912
    s_lshl_b32 s68, s3, 4
    v_lshl_add_u32 v12, v2, 1, s68
    ds_read_u16 v15, v12 offset:7104
    s_waitcnt vmcnt(12)
    v_mov_b32 v44, 0
    v_mov_b32 v45, 0
    v_mov_b32 v46, 0
    v_mov_b32 v47, 0
    v_mov_b32 v48, 0
    v_mov_b32 v49, 0
    v_mov_b32 v50, 0
    v_mov_b32 v51, 0
    s_waitcnt lgkmcnt(0)
    v_dot2c_f32_bf16 v44, v64, v32
    v_dot2c_f32_bf16 v45, v76, v32
    v_dot2c_f32_bf16 v46, v88, v32
    v_dot2c_f32_bf16 v47, v100, v32
    v_dot2c_f32_bf16 v48, v112, v32
    v_dot2c_f32_bf16 v49, v124, v32
    v_dot2c_f32_bf16 v50, v136, v32
    v_dot2c_f32_bf16 v51, v148, v32
    v_dot2c_f32_bf16 v44, v65, v33
    v_dot2c_f32_bf16 v45, v77, v33
    v_dot2c_f32_bf16 v46, v89, v33
    v_dot2c_f32_bf16 v47, v101, v33
    v_dot2c_f32_bf16 v48, v113, v33
    v_dot2c_f32_bf16 v49, v125, v33
    v_dot2c_f32_bf16 v50, v137, v33
    v_dot2c_f32_bf16 v51, v149, v33
    v_dot2c_f32_bf16 v44, v66, v34
    v_dot2c_f32_bf16 v45, v78, v34
    v_dot2c_f32_bf16 v46, v90, v34
    v_dot2c_f32_bf16 v47, v102, v34
    v_dot2c_f32_bf16 v48, v114, v34
    v_dot2c_f32_bf16 v49, v126, v34
    v_dot2c_f32_bf16 v50, v138, v34
    v_dot2c_f32_bf16 v51, v150, v34
    v_dot2c_f32_bf16 v44, v67, v35
    v_dot2c_f32_bf16 v45, v79, v35
    v_dot2c_f32_bf16 v46, v91, v35
    v_dot2c_f32_bf16 v47, v103, v35
    v_dot2c_f32_bf16 v48, v115, v35
    v_dot2c_f32_bf16 v49, v127, v35
    v_dot2c_f32_bf16 v50, v139, v35
    v_dot2c_f32_bf16 v51, v151, v35
    v_dot2c_f32_bf16 v44, v68, v36
    v_dot2c_f32_bf16 v45, v80, v36
    v_dot2c_f32_bf16 v46, v92, v36
    v_dot2c_f32_bf16 v47, v104, v36
    v_dot2c_f32_bf16 v48, v116, v36
    v_dot2c_f32_bf16 v49, v128, v36
    v_dot2c_f32_bf16 v50, v140, v36
    v_dot2c_f32_bf16 v51, v152, v36
    v_dot2c_f32_bf16 v44, v69, v37
    v_dot2c_f32_bf16 v45, v81, v37
    v_dot2c_f32_bf16 v46, v93, v37
    v_dot2c_f32_bf16 v47, v105, v37
    v_dot2c_f32_bf16 v48, v117, v37
    v_dot2c_f32_bf16 v49, v129, v37
    v_dot2c_f32_bf16 v50, v141, v37
    v_dot2c_f32_bf16 v51, v153, v37
    v_dot2c_f32_bf16 v44, v70, v38
    v_dot2c_f32_bf16 v45, v82, v38
    v_dot2c_f32_bf16 v46, v94, v38
    v_dot2c_f32_bf16 v47, v106, v38
    v_dot2c_f32_bf16 v48, v118, v38
    v_dot2c_f32_bf16 v49, v130, v38
    v_dot2c_f32_bf16 v50, v142, v38
    v_dot2c_f32_bf16 v51, v154, v38
    v_dot2c_f32_bf16 v44, v71, v39
    v_dot2c_f32_bf16 v45, v83, v39
    v_dot2c_f32_bf16 v46, v95, v39
    v_dot2c_f32_bf16 v47, v107, v39
    v_dot2c_f32_bf16 v48, v119, v39
    v_dot2c_f32_bf16 v49, v131, v39
    v_dot2c_f32_bf16 v50, v143, v39
    v_dot2c_f32_bf16 v51, v155, v39
    v_dot2c_f32_bf16 v44, v72, v40
    v_dot2c_f32_bf16 v45, v84, v40
    v_dot2c_f32_bf16 v46, v96, v40
    v_dot2c_f32_bf16 v47, v108, v40
    v_dot2c_f32_bf16 v48, v120, v40
    v_dot2c_f32_bf16 v49, v132, v40
    v_dot2c_f32_bf16 v50, v144, v40
    v_dot2c_f32_bf16 v51, v156, v40
    v_dot2c_f32_bf16 v44, v73, v41
    v_dot2c_f32_bf16 v45, v85, v41
    v_dot2c_f32_bf16 v46, v97, v41
    v_dot2c_f32_bf16 v47, v109, v41
    v_dot2c_f32_bf16 v48, v121, v41
    v_dot2c_f32_bf16 v49, v133, v41
    v_dot2c_f32_bf16 v50, v145, v41
    v_dot2c_f32_bf16 v51, v157, v41
    v_dot2c_f32_bf16 v44, v74, v42
    v_dot2c_f32_bf16 v45, v86, v42
    v_dot2c_f32_bf16 v46, v98, v42
    v_dot2c_f32_bf16 v47, v110, v42
    v_dot2c_f32_bf16 v48, v122, v42
    v_dot2c_f32_bf16 v49, v134, v42
    v_dot2c_f32_bf16 v50, v146, v42
    v_dot2c_f32_bf16 v51, v158, v42
    v_dot2c_f32_bf16 v44, v75, v43
    v_dot2c_f32_bf16 v45, v87, v43
    v_dot2c_f32_bf16 v46, v99, v43
    v_dot2c_f32_bf16 v47, v111, v43
    v_dot2c_f32_bf16 v48, v123, v43
    v_dot2c_f32_bf16 v49, v135, v43
    v_dot2c_f32_bf16 v50, v147, v43
    v_dot2c_f32_bf16 v51, v159, v43
    v_add_f32_dpp v44, v44, v44 quad_perm:[1,0,3,2] row_mask:0xf bank_mask:0xf
    v_add_f32_dpp v45, v45, v45 quad_perm:[1,0,3,2] row_mask:0xf bank_mask:0xf
    v_add_f32_dpp v46, v46, v46 quad_perm:[1,0,3,2] row_mask:0xf bank_mask:0xf
    v_add_f32_dpp v47, v47, v47 quad_perm:[1,0,3,2] row_mask:0xf bank_mask:0xf
    v_add_f32_dpp v48, v48, v48 quad_perm:[1,0,3,2] row_mask:0xf bank_mask:0xf
    v_add_f32_dpp v49, v49, v49 quad_perm:[1,0,3,2] row_mask:0xf bank_mask:0xf
    v_add_f32_dpp v50, v50, v50 quad_perm:[1,0,3,2] row_mask:0xf bank_mask:0xf
    v_add_f32_dpp v51, v51, v51 quad_perm:[1,0,3,2] row_mask:0xf bank_mask:0xf
    v_add_f32_dpp v44, v44, v44 quad_perm:[2,3,0,1] row_mask:0xf bank_mask:0xf
    v_add_f32_dpp v45, v45, v45 quad_perm:[2,3,0,1] row_mask:0xf bank_mask:0xf
    v_add_f32_dpp v46, v46, v46 quad_perm:[2,3,0,1] row_mask:0xf bank_mask:0xf
    v_add_f32_dpp v47, v47, v47 quad_perm:[2,3,0,1] row_mask:0xf bank_mask:0xf
    v_add_f32_dpp v48, v48, v48 quad_perm:[2,3,0,1] row_mask:0xf bank_mask:0xf
    v_add_f32_dpp v49, v49, v49 quad_perm:[2,3,0,1] row_mask:0xf bank_mask:0xf
    v_add_f32_dpp v50, v50, v50 quad_perm:[2,3,0,1] row_mask:0xf bank_mask:0xf
    v_add_f32_dpp v51, v51, v51 quad_perm:[2,3,0,1] row_mask:0xf bank_mask:0xf
    v_add_f32_dpp v44, v44, v44 row_half_mirror row_mask:0xf bank_mask:0xf
    v_add_f32_dpp v45, v45, v45 row_half_mirror row_mask:0xf bank_mask:0xf
    v_add_f32_dpp v46, v46, v46 row_half_mirror row_mask:0xf bank_mask:0xf
    v_add_f32_dpp v47, v47, v47 row_half_mirror row_mask:0xf bank_mask:0xf
    v_add_f32_dpp v48, v48, v48 row_half_mirror row_mask:0xf bank_mask:0xf
    v_add_f32_dpp v49, v49, v49 row_half_mirror row_mask:0xf bank_mask:0xf
    v_add_f32_dpp v50, v50, v50 row_half_mirror row_mask:0xf bank_mask:0xf
    v_add_f32_dpp v51, v51, v51 row_half_mirror row_mask:0xf bank_mask:0xf
    s_mov_b32 s72, 0x3d93cd3a
    s_mov_b32 s1, 0x3fb8aa3b
    v_cvt_pk_bf16_f32 v32, v44, v45
    v_cvt_pk_bf16_f32 v33, v46, v47
    v_cvt_pk_bf16_f32 v34, v48, v49
    v_cvt_pk_bf16_f32 v35, v50, v51
    v_lshlrev_b32 v44, 16, v32
    v_and_b32 v45, 0xffff0000, v32
    v_lshlrev_b32 v46, 16, v33
    v_and_b32 v47, 0xffff0000, v33
    v_lshlrev_b32 v48, 16, v34
    v_and_b32 v49, 0xffff0000, v34
    v_lshlrev_b32 v50, 16, v35
    v_and_b32 v51, 0xffff0000, v35
    v_mul_f32 v44, s72, v44
    v_mul_f32 v45, s72, v45
    v_mul_f32 v46, s72, v46
    v_mul_f32 v47, s72, v47
    v_mul_f32 v48, s72, v48
    v_mul_f32 v49, s72, v49
    v_mul_f32 v50, s72, v50
    v_mul_f32 v51, s72, v51
    v_cvt_pk_bf16_f32 v32, v44, v45
    v_cvt_pk_bf16_f32 v33, v46, v47
    v_cvt_pk_bf16_f32 v34, v48, v49
    v_cvt_pk_bf16_f32 v35, v50, v51
    v_lshlrev_b32 v44, 16, v32
    v_and_b32 v45, 0xffff0000, v32
    v_lshlrev_b32 v46, 16, v33
    v_and_b32 v47, 0xffff0000, v33
    v_lshlrev_b32 v48, 16, v34
    v_and_b32 v49, 0xffff0000, v34
    v_lshlrev_b32 v50, 16, v35
    v_and_b32 v51, 0xffff0000, v35
    v_mul_f32 v44, s1, v44
    v_mul_f32 v45, s1, v45
    v_mul_f32 v46, s1, v46
    v_mul_f32 v47, s1, v47
    v_mul_f32 v48, s1, v48
    v_mul_f32 v49, s1, v49
    v_mul_f32 v50, s1, v50
    v_mul_f32 v51, s1, v51
    v_max3_f32 v100, v44, v45, v46
    v_max3_f32 v101, v47, v48, v49
    v_max3_f32 v100, v100, v50, v51
    v_max_f32 v100, v100, v101
    s_nop 1
    v_max_f32_dpp v100, v100, v100 row_ror:8 row_mask:0xf bank_mask:0xf
    v_mov_b32 v101, v100
    s_nop 1
    v_permlane16_swap_b32 v100, v101
    v_max_f32 v100, v100, v101
    v_mov_b32 v101, v100
    s_nop 1
    v_permlane32_swap_b32 v100, v101
    v_max_f32 v100, v100, v101
    v_sub_f32 v44, v44, v100
    v_sub_f32 v45, v45, v100
    v_sub_f32 v46, v46, v100
    v_sub_f32 v47, v47, v100
    v_sub_f32 v48, v48, v100
    v_sub_f32 v49, v49, v100
    v_sub_f32 v50, v50, v100
    v_sub_f32 v51, v51, v100
    v_exp_f32 v44, v44
    v_exp_f32 v45, v45
    v_exp_f32 v46, v46
    v_exp_f32 v47, v47
    v_exp_f32 v48, v48
    v_exp_f32 v49, v49
    v_exp_f32 v50, v50
    v_exp_f32 v51, v51
    v_cvt_pk_bf16_f32 v102, v44, v44
    v_and_b32 v64, v102, v8
    v_and_b32 v65, v102, v9
    v_and_b32 v66, v102, v10
    v_and_b32 v67, v102, v11
    v_cvt_pk_bf16_f32 v103, v45, v45
    v_and_b32 v68, v103, v8
    v_and_b32 v69, v103, v9
    v_and_b32 v70, v103, v10
    v_and_b32 v71, v103, v11
    v_cvt_pk_bf16_f32 v102, v46, v46
    v_and_b32 v72, v102, v8
    v_and_b32 v73, v102, v9
    v_and_b32 v74, v102, v10
    v_and_b32 v75, v102, v11
    v_cvt_pk_bf16_f32 v103, v47, v47
    v_and_b32 v76, v103, v8
    v_and_b32 v77, v103, v9
    v_and_b32 v78, v103, v10
    v_and_b32 v79, v103, v11
    v_cvt_pk_bf16_f32 v102, v48, v48
    v_and_b32 v80, v102, v8
    v_and_b32 v81, v102, v9
    v_and_b32 v82, v102, v10
    v_and_b32 v83, v102, v11
    v_cvt_pk_bf16_f32 v103, v49, v49
    v_and_b32 v84, v103, v8
    v_and_b32 v85, v103, v9
    v_and_b32 v86, v103, v10
    v_and_b32 v87, v103, v11
    v_cvt_pk_bf16_f32 v102, v50, v50
    v_and_b32 v88, v102, v8
    v_and_b32 v89, v102, v9
    v_and_b32 v90, v102, v10
    v_and_b32 v91, v102, v11
    v_cvt_pk_bf16_f32 v103, v51, v51
    v_and_b32 v92, v103, v8
    v_and_b32 v93, v103, v9
    v_and_b32 v94, v103, v10
    v_and_b32 v95, v103, v11
    v_add_f32 v101, v44, v45
    v_add_f32 v101, v101, v46
    v_add_f32 v101, v101, v47
    v_add_f32 v101, v101, v48
    v_add_f32 v101, v101, v49
    v_add_f32 v101, v101, v50
    v_add_f32 v101, v101, v51
    s_nop 1
    v_add_f32_dpp v101, v101, v101 row_ror:8 row_mask:0xf bank_mask:0xf
    v_mov_b32 v102, v101
    s_nop 1
    v_permlane16_swap_b32 v101, v102
    v_add_f32 v101, v101, v102
    v_mov_b32 v102, v101
    s_nop 1
    v_permlane32_swap_b32 v101, v102
    v_add_f32 v101, v101, v102
    v_mov_b32 v32, 0
    v_mov_b32 v33, 0
    v_mov_b32 v34, 0
    v_mov_b32 v35, 0
    v_mov_b32 v36, 0
    v_mov_b32 v37, 0
    v_mov_b32 v38, 0
    v_mov_b32 v39, 0
    v_mov_b32 v40, 0
    v_mov_b32 v41, 0
    v_mov_b32 v42, 0
    v_mov_b32 v43, 0
    s_mul_i32 s68, s3, 832
    v_add_u32 v12, s68, v5
    v_mov_b32 v13, s68
    ds_write_b64 v13, v[100:101] offset:768
    v_lshl_or_b32 v15, v15, 16, v15
    v_and_b32 v96, v15, v8
    v_and_b32 v97, v15, v9
    v_and_b32 v98, v15, v10
    v_and_b32 v99, v15, v11
    v_lshlrev_b32 v15, 5, v3
    v_lshl_add_u32 v15, v2, 2, v15
    v_mov_b32 v105, s76
    v_mov_b32 v107, s76
    v_mov_b32 v109, s76
    v_mov_b32 v111, s76
    s_cmp_lt_u32 s3, 4
    s_cbranch_scc0 L_v2
    s_waitcnt vmcnt(0)
    s_branch L_pv
L_v2:
    s_mov_b32 s70, 393216
    s_waitcnt vmcnt(5)
    buffer_load_dwordx4 v[208:211], v4, s[36:39], s70 offen offset:0 nt
    s_waitcnt vmcnt(5)
    buffer_load_dwordx4 v[212:215], v4, s[36:39], s70 offen offset:128 nt
    s_waitcnt vmcnt(5)
    buffer_load_dwordx4 v[216:219], v4, s[36:39], s70 offen offset:256 nt
    s_mov_b32 s70, 491520
    s_waitcnt vmcnt(5)
    buffer_load_dwordx4 v[220:223], v4, s[36:39], s70 offen offset:0 nt
    s_waitcnt vmcnt(5)
    buffer_load_dwordx4 v[224:227], v4, s[36:39], s70 offen offset:128 nt
    s_waitcnt vmcnt(5)
    buffer_load_dwordx4 v[228:231], v4, s[36:39], s70 offen offset:256 nt
    s_mov_b32 s70, 589824
    s_waitcnt vmcnt(5)
    buffer_load_dwordx4 v[232:235], v4, s[36:39], s70 offen offset:0 nt
    s_waitcnt vmcnt(5)
    buffer_load_dwordx4 v[236:239], v4, s[36:39], s70 offen offset:128 nt
    s_waitcnt vmcnt(5)
    buffer_load_dwordx4 v[240:243], v4, s[36:39], s70 offen offset:256 nt
    s_mov_b32 s70, 688128
    s_waitcnt vmcnt(5)
    buffer_load_dwordx4 v[244:247], v4, s[36:39], s70 offen offset:0 nt
    s_waitcnt vmcnt(5)
    buffer_load_dwordx4 v[248:251], v4, s[36:39], s70 offen offset:128 nt
    ds_write_b32 v55, v54
    s_waitcnt vmcnt(5)
    buffer_load_dwordx4 v[252:255], v4, s[36:39], s70 offen offset:256 nt
    s_cmp_lt_u32 s3, 4
    s_cbranch_scc1 L_a1
    s_branch L_pv
L_a1:
    s_waitcnt lgkmcnt(0)
    s_add_u32 s76, s76, 0x9e3779b9
    s_mov_b32 s60, s18
    s_mov_b32 s61, s19
    s_mov_b32 s62, 3072
    s_mov_b32 s63, 0x20000
    s_lshr_b32 s68, s30, 3
    s_mul_i32 s68, s68, 3
    s_add_u32 s68, s68, s3
    s_min_u32 s72, s64, 2
    s_add_u32 s69, s72, 12
    s_cmp_eq_u32 s3, 3
    s_cselect_b32 s68, s69, s68
    s_mul_i32 s69, s74, 15
    s_add_u32 s68, s68, s69
    s_lshl_b32 s68, s68, 12
    s_add_u32 s68, s68, 1476608
    s_add_u32 s69, s68, 491520
    s_mul_i32 s1, s74, 3
    s_add_u32 s1, s1, s72
    s_lshl_b32 s1, s1, 7
    v_lshlrev_b32 v12, 4, v1
    v_and_b32 v13, 31, v1
    v_lshlrev_b32 v13, 2, v13
    s_cmp_eq_u32 s3, 3
    s_cbranch_scc0 L_nob1
    buffer_load_dword v0, v13, s[60:63], s1 offen
L_nob1:
    s_mov_b32 s71, 200000
    buffer_load_dwordx4 v[16:19], v12, s[48:51], s68 offen offset:0 sc1
    buffer_load_dwordx4 v[20:23], v12, s[48:51], s68 offen offset:1024 sc1
    buffer_load_dwordx4 v[24:27], v12, s[48:51], s68 offen offset:2048 sc1
    buffer_load_dwordx4 v[28:31], v12, s[48:51], s68 offen offset:3072 sc1
    s_branch L_qpoll_w
L_qpoll:
    buffer_load_dwordx4 v[16:19], v12, s[48:51], s68 offen offset:0 sc1
    buffer_load_dwordx4 v[20:23], v12, s[48:51], s68 offen offset:1024 sc1
    buffer_load_dwordx4 v[24:27], v12, s[48:51], s68 offen offset:2048 sc1
    buffer_load_dwordx4 v[28:31], v12, s[48:51], s68 offen offset:3072 sc1
L_qpoll_w:
    s_waitcnt vmcnt(0)
    v_bitop3_b32 v32, v17, v19, s76 bitop3:0x7e
    v_bitop3_b32 v33, v21, v23, s76 bitop3:0x7e
    v_bitop3_b32 v34, v25, v27, s76 bitop3:0x7e
    v_bitop3_b32 v35, v29, v31, s76 bitop3:0x7e
    v_or3_b32 v32, v32, v33, v34
    v_or_b32 v32, v32, v35
    v_cmp_ne_u32 vcc, 0, v32
    s_nop 0
    s_cbranch_vccz L_qpoll_d
    s_mov_b64 exec, vcc
    s_sleep 8
    s_sub_u32 s71, s71, 1
    s_cbranch_scc1 L_qpoll_d
    s_and_b32 s0, s71, 31
    s_cbranch_scc1 L_qpoll
    s_cmp_lt_u32 s75, 30
    s_cbranch_scc0 L_nop1_1
    s_mov_b64 exec, -1
    v_lshlrev_b32 v44, 4, v1
    ds_read_b128 v[36:39], v44 offset:7232
    ds_read_b128 v[40:43], v44 offset:8256
    v_lshrrev_b32 v44, 5, v1
    s_lshl_b32 s0, s75, 2
    s_add_u32 s0, s0, 0
    v_add_u32 v44, s0, v44
    v_mul_u32_u24 v45, 137, v44
    v_lshrrev_b32 v45, 11, v45
    v_mul_u32_u24 v46, 15, v45
    v_sub_u32 v44, v44, v46
    v_lshl_add_u32 v44, v44, 3, v45
    v_lshlrev_b32 v44, 9, v44
    v_and_b32 v45, 31, v1
    v_lshl_add_u32 v44, v45, 4, v44
    s_mul_i32 s0, s74, 61440
    s_add_u32 s0, s0, 1968128
    s_waitcnt lgkmcnt(0)
    buffer_store_dwordx4 v[36:39], v44, s[48:51], s0 offen sc1
    v_lshrrev_b32 v44, 5, v1
    s_lshl_b32 s0, s75, 2
    s_add_u32 s0, s0, 2
    v_add_u32 v44, s0, v44
    v_mul_u32_u24 v45, 137, v44
    v_lshrrev_b32 v45, 11, v45
    v_mul_u32_u24 v46, 15, v45
    v_sub_u32 v44, v44, v46
    v_lshl_add_u32 v44, v44, 3, v45
    v_lshlrev_b32 v44, 9, v44
    v_and_b32 v45, 31, v1
    v_lshl_add_u32 v44, v45, 4, v44
    s_mul_i32 s0, s74, 61440
    s_add_u32 s0, s0, 1968128
    s_waitcnt lgkmcnt(0)
    buffer_store_dwordx4 v[40:43], v44, s[48:51], s0 offen sc1
    s_nop 1
L_nop1_1:
    s_mov_b64 exec, vcc
    buffer_load_dwordx4 v[16:19], v12, s[48:51], s69 offen offset:0 sc1
    buffer_load_dwordx4 v[20:23], v12, s[48:51], s69 offen offset:1024 sc1
    buffer_load_dwordx4 v[24:27], v12, s[48:51], s69 offen offset:2048 sc1
    buffer_load_dwordx4 v[28:31], v12, s[48:51], s69 offen offset:3072 sc1
    s_branch L_qpoll_w
L_qpoll_d:
    s_mov_b64 exec, s[78:79]
    v_add_f32 v16, v16, v20
    v_add_f32 v18, v18, v22
    v_add_f32 v24, v24, v28
    v_add_f32 v26, v26, v30
    v_add_f32 v16, v16, v24
    v_add_f32 v18, v18, v26
    v_mov_b32 v17, v16
    v_mov_b32 v19, v18
    s_nop 0
    v_permlane32_swap_b32 v16, v17
    v_permlane32_swap_b32 v18, v19
    v_add_f32 v16, v16, v17
    v_add_f32 v18, v18, v19
    v_cvt_pk_bf16_f32 v35, v16, v18
    s_cmp_eq_u32 s3, 3
    s_cbranch_scc0 L_noh
    v_lshlrev_b32 v16, 16, v35
    v_and_b32 v17, 0xffff0000, v35
    v_lshlrev_b32 v18, 16, v0
    v_and_b32 v19, 0xffff0000, v0
    v_add_f32 v16, v16, v18
    v_add_f32 v17, v17, v19
    v_cvt_pk_bf16_f32 v35, v16, v17
    v_lshlrev_b32 v16, 16, v35
    v_and_b32 v17, 0xffff0000, v35
    v_max_f32 v16, 0, v16
    v_max_f32 v17, 0, v17
    v_mul_f32 v16, v16, v16
    v_mul_f32 v17, v17, v17
    v_cvt_pk_bf16_f32 v35, v16, v17
    s_nop 1
L_noh:
    s_lshl_b32 s68, s3, 7
    s_cmp_eq_u32 s3, 3
    s_cselect_b32 s68, 448, s68
    v_add_u32 v13, s68, v13
    ds_write_b32 v13, v35 offset:6656
    s_waitcnt lgkmcnt(0)
    s_mov_b64 exec, 1
    ds_add_u32 v14, v54
    s_mov_b64 exec, -1
    s_branch L_qk
L_pv:
    v_sub_u32 v118, 7, v3
    v_min_u32 v118, v118, v3
    v_lshrrev_b32 v119, 2, v3
    v_mul_u32_u24 v116, 5760, v2
    v_lshl_add_u32 v116, v118, 4, v116
    v_lshl_add_u32 v116, v119, 9, v116
    v_lshlrev_b32 v117, 2, v118
    v_bfe_u32 v119, v1, 5, 1
    v_lshl_add_u32 v117, v119, 1, v117
    s_sub_u32 s101, s2, 240
    s_mul_i32 s101, s101, 5
    s_add_u32 s101, s101, s3
    s_lshl_b32 s68, s101, 4
    v_add_u32 v117, s68, v117
    s_waitcnt vmcnt(23)
    v_mfma_f32_16x16x32_bf16 v[32:35], v[64:67], v[160:163], v[32:35]
    s_waitcnt vmcnt(22)
    v_mfma_f32_16x16x32_bf16 v[36:39], v[64:67], v[164:167], v[36:39]
    s_waitcnt vmcnt(21)
    v_mfma_f32_16x16x32_bf16 v[40:43], v[64:67], v[168:171], v[40:43]
    s_waitcnt vmcnt(20)
    v_mfma_f32_16x16x32_bf16 v[32:35], v[68:71], v[172:175], v[32:35]
    s_waitcnt vmcnt(19)
    v_mfma_f32_16x16x32_bf16 v[36:39], v[68:71], v[176:179], v[36:39]
    s_waitcnt vmcnt(18)
    v_mfma_f32_16x16x32_bf16 v[40:43], v[68:71], v[180:183], v[40:43]
    s_waitcnt vmcnt(17)
    v_mfma_f32_16x16x32_bf16 v[32:35], v[72:75], v[184:187], v[32:35]
    s_waitcnt vmcnt(16)
    v_mfma_f32_16x16x32_bf16 v[36:39], v[72:75], v[188:191], v[36:39]
    s_waitcnt vmcnt(15)
    v_mfma_f32_16x16x32_bf16 v[40:43], v[72:75], v[192:195], v[40:43]
    s_waitcnt vmcnt(14)
    v_mfma_f32_16x16x32_bf16 v[32:35], v[76:79], v[196:199], v[32:35]
    s_waitcnt vmcnt(13)
    v_mfma_f32_16x16x32_bf16 v[36:39], v[76:79], v[200:203], v[36:39]
    s_waitcnt vmcnt(12)
    v_mfma_f32_16x16x32_bf16 v[40:43], v[76:79], v[204:207], v[40:43]
    s_waitcnt vmcnt(11)
    v_mfma_f32_16x16x32_bf16 v[32:35], v[80:83], v[208:211], v[32:35]
    s_waitcnt vmcnt(10)
    v_mfma_f32_16x16x32_bf16 v[36:39], v[80:83], v[212:215], v[36:39]
    s_waitcnt vmcnt(9)
    v_mfma_f32_16x16x32_bf16 v[40:43], v[80:83], v[216:219], v[40:43]
    s_waitcnt vmcnt(8)
    v_mfma_f32_16x16x32_bf16 v[32:35], v[84:87], v[220:223], v[32:35]
    s_waitcnt vmcnt(7)
    v_mfma_f32_16x16x32_bf16 v[36:39], v[84:87], v[224:227], v[36:39]
    s_waitcnt vmcnt(6)
    v_mfma_f32_16x16x32_bf16 v[40:43], v[84:87], v[228:231], v[40:43]
    s_waitcnt vmcnt(5)
    v_mfma_f32_16x16x32_bf16 v[32:35], v[88:91], v[232:235], v[32:35]
    s_waitcnt vmcnt(4)
    v_mfma_f32_16x16x32_bf16 v[36:39], v[88:91], v[236:239], v[36:39]
    s_waitcnt vmcnt(3)
    v_mfma_f32_16x16x32_bf16 v[40:43], v[88:91], v[240:243], v[40:43]
    buffer_load_dwordx4 v[16:19], v6, s[56:59], 0 offen offset:0 nt
    buffer_load_dwordx4 v[20:23], v6, s[56:59], 0 offen offset:1280 nt
    buffer_load_dwordx4 v[24:27], v6, s[56:59], 0 offen offset:2560 nt
    buffer_load_dwordx4 v[28:31], v6, s[56:59], 0 offen offset:3840 nt
    buffer_load_dwordx4 v[112:115], v7, s[52:55], 0 offen nt
    s_waitcnt vmcnt(7)
    v_mfma_f32_16x16x32_bf16 v[32:35], v[92:95], v[244:247], v[32:35]
    s_waitcnt vmcnt(6)
    v_mfma_f32_16x16x32_bf16 v[36:39], v[92:95], v[248:251], v[36:39]
    s_waitcnt vmcnt(5)
    v_mfma_f32_16x16x32_bf16 v[40:43], v[92:95], v[252:255], v[40:43]
    s_nop 3
    v_permlane32_swap_b32 v32, v33
    v_permlane32_swap_b32 v34, v35
    v_permlane32_swap_b32 v36, v37
    v_permlane32_swap_b32 v38, v39
    v_add_f32_dpp v44, v33, v32 row_ror:8 row_mask:0xf bank_mask:0x3
    v_add_f32_dpp v44, v34, v35 row_ror:8 row_mask:0xf bank_mask:0xc
    ds_write_b32 v12, v44 offset:0
    v_permlane32_swap_b32 v40, v41
    v_permlane32_swap_b32 v42, v43
    v_add_f32_dpp v45, v37, v36 row_ror:8 row_mask:0xf bank_mask:0x3
    v_add_f32_dpp v45, v38, v39 row_ror:8 row_mask:0xf bank_mask:0xc
    ds_write_b32 v12, v45 offset:256
    v_add_f32_dpp v46, v41, v40 row_ror:8 row_mask:0xf bank_mask:0x3
    v_add_f32_dpp v46, v42, v43 row_ror:8 row_mask:0xf bank_mask:0xc
    ds_write_b32 v12, v46 offset:512
    s_cmp_lt_u32 s3, 4
    s_cbranch_scc0 L_T1
    s_cmp_eq_u32 s3, 1
    s_cbranch_scc0 L_nochk
    s_lshl_b32 s68, s74, 8
    s_add_u32 s68, s68, 1474560
    v_and_b32 v13, 31, v1
    v_lshlrev_b32 v13, 3, v13
    buffer_load_dwordx2 v[44:45], v13, s[48:51], s68 offen sc1
    s_getreg_b32 s68, hwreg(HW_REG_XCC_ID)
    s_waitcnt vmcnt(0)
    v_xor_b32 v44, s68, v44
    v_xor_b32 v45, s76, v45
    v_or_b32 v44, v44, v45
    v_cmp_ne_u32 vcc, 0, v44
    s_nop 0
    s_cbranch_vccnz L_nochk
    ds_write_b32 v14, v54 offset:8
L_nochk:
    s_cmp_lt_u32 s75, 30
    s_cselect_b32 s58, 39808, 0
    s_cselect_b32 s54, 9088, 0
    s_mov_b32 s71, 200000
L_wfb:
    ds_read_b128 v[44:47], v14 offset:16
    ds_read_b128 v[48:51], v14 offset:32
    s_waitcnt lgkmcnt(0)
    v_and_b32 v45, v45, v47
    v_and_b32 v49, v49, v51
    v_and_b32 v45, v45, v49
    s_nop 0
    v_readfirstlane_b32 s68, v45
    s_nop 0
    s_cmp_lg_u32 s68, 0
    s_nop 1
    s_cbranch_scc1 L_wfb_d
    s_sleep 1
    s_sub_u32 s71, s71, 1
    s_cbranch_scc0 L_wfb
L_wfb_d:
    buffer_load_dwordx4 v[16:19], v6, s[56:59], 0 offen offset:0 nt
    buffer_load_dwordx4 v[20:23], v6, s[56:59], 0 offen offset:1280 nt
    buffer_load_dwordx4 v[24:27], v6, s[56:59], 0 offen offset:2560 nt
    buffer_load_dwordx4 v[28:31], v6, s[56:59], 0 offen offset:3840 nt
    buffer_load_dwordx4 v[112:115], v7, s[52:55], 0 offen nt
L_T1:
    s_mul_i32 s69, s77, 5760
    s_mul_i32 s70, s73, 384
    s_add_u32 s70, s70, s69
    s_add_u32 s70, s70, 0
    s_not_b32 s0, s76
    v_mov_b32 v65, s0
    v_cmp_eq_u32 s[32:33], 1, v3
    s_mov_b64 s[34:35], 4
    s_waitcnt lgkmcnt(0)
    s_barrier
    s_cmp_lt_u32 s3, 6
    s_cbranch_scc0 L_nocomb
    ds_read_b64 v[52:53], v56 offset:768
    ds_read_b128 v[44:47], v57 offset:0
    s_waitcnt lgkmcnt(1)
    v_max_f32_dpp v108, v52, v52 quad_perm:[1,0,3,2] row_mask:0xf bank_mask:0xf
    s_nop 1
    v_max_f32_dpp v108, v108, v108 quad_perm:[2,3,0,1] row_mask:0xf bank_mask:0xf
    s_nop 1
    v_max_f32_dpp v108, v108, v108 row_half_mirror row_mask:0xf bank_mask:0xf
    v_sub_f32 v52, v52, v108
    v_exp_f32 v52, v52
    s_waitcnt lgkmcnt(0)
    v_mul_f32 v44, v52, v44
    v_mul_f32 v45, v52, v45
    v_mul_f32 v46, v52, v46
    v_mul_f32 v47, v52, v47
    v_mul_f32 v110, v52, v53
    v_add_f32_dpp v44, v44, v44 quad_perm:[1,0,3,2] row_mask:0xf bank_mask:0xf
    v_add_f32_dpp v45, v45, v45 quad_perm:[1,0,3,2] row_mask:0xf bank_mask:0xf
    v_add_f32_dpp v46, v46, v46 quad_perm:[1,0,3,2] row_mask:0xf bank_mask:0xf
    v_add_f32_dpp v47, v47, v47 quad_perm:[1,0,3,2] row_mask:0xf bank_mask:0xf
    v_add_f32_dpp v110, v110, v110 quad_perm:[1,0,3,2] row_mask:0xf bank_mask:0xf
    v_add_f32_dpp v44, v44, v44 quad_perm:[2,3,0,1] row_mask:0xf bank_mask:0xf
    v_add_f32_dpp v45, v45, v45 quad_perm:[2,3,0,1] row_mask:0xf bank_mask:0xf
    v_add_f32_dpp v46, v46, v46 quad_perm:[2,3,0,1] row_mask:0xf bank_mask:0xf
    v_add_f32_dpp v47, v47, v47 quad_perm:[2,3,0,1] row_mask:0xf bank_mask:0xf
    v_add_f32_dpp v110, v110, v110 quad_perm:[2,3,0,1] row_mask:0xf bank_mask:0xf
    v_add_f32_dpp v44, v44, v44 row_half_mirror row_mask:0xf bank_mask:0xf
    v_add_f32_dpp v45, v45, v45 row_half_mirror row_mask:0xf bank_mask:0xf
    v_add_f32_dpp v46, v46, v46 row_half_mirror row_mask:0xf bank_mask:0xf
    v_add_f32_dpp v47, v47, v47 row_half_mirror row_mask:0xf bank_mask:0xf
    v_add_f32_dpp v110, v110, v110 row_half_mirror row_mask:0xf bank_mask:0xf
    v_cndmask_b32 v104, v44, v46, s[32:33]
    v_cndmask_b32 v106, v45, v47, s[32:33]
    v_cndmask_b32 v104, v104, v108, s[34:35]
    v_cndmask_b32 v106, v106, v110, s[34:35]
    s_mov_b32 s34, 0x03030307
    s_mov_b32 s35, 0x03030303
    s_and_b64 s[34:35], s[34:35], s[78:79]
    s_mov_b64 exec, s[34:35]
    buffer_store_dwordx4 v[104:107], v58, s[48:51], s66 offen
    ds_write_b128 v58, v[104:107] offset:14400
    s_mov_b64 exec, s[78:79]
    s_waitcnt vmcnt(1)
    s_branch L_combined
L_nocomb:
    s_mov_b64 s[34:35], 0
    s_waitcnt vmcnt(0)
L_combined:
    s_cmp_lt_u32 s75, 30
    s_cbranch_scc0 L_final
    s_mov_b32 s71, 200000
    v_bitop3_b32 v76, v65, v67, s76 bitop3:0x7e
    v_bitop3_b32 v77, v69, v71, s76 bitop3:0x7e
    v_bitop3_b32 v78, v73, v75, s76 bitop3:0x7e
    v_or3_b32 v76, v76, v77, v78
    v_cmp_ne_u32 vcc, 0, v76
    s_nop 0
    s_mov_b64 s[36:37], vcc
    s_mov_b64 exec, vcc
    s_cbranch_execz L_nor2
    buffer_load_dwordx4 v[64:67], v60, s[48:51], s70 offen offset:0 sc1
    buffer_load_dwordx4 v[68:71], v60, s[48:51], s70 offen offset:16 sc1
    buffer_load_dwordx4 v[72:75], v59, s[48:51], s70 offen offset:256 sc1
L_nor2:
    s_mov_b64 exec, s[78:79]
    ds_read_b32 v53, v14 offset:8
    v_mov_b32 v32, 0
    v_mov_b32 v33, 0
    v_mov_b32 v34, 0
    v_mov_b32 v35, 0
    v_mov_b32 v36, 0
    v_mov_b32 v37, 0
    v_mov_b32 v38, 0
    v_mov_b32 v39, 0
    s_nop 1
    v_mfma_f32_16x16x32_bf16 v[36:39], v[96:99], v[112:115], v[36:39]
    s_lshl_b32 s68, s3, 9
    s_add_u32 s68, s68, s66
    s_add_u32 s68, s68, 4608
    s_nop 4
    v_permlane32_swap_b32 v36, v37
    v_permlane32_swap_b32 v38, v39
    s_nop 0
    v_add_f32_dpp v40, v37, v36 row_ror:8 row_mask:0xf bank_mask:0x3
    v_add_f32_dpp v40, v38, v39 row_ror:8 row_mask:0xf bank_mask:0xc
    s_waitcnt lgkmcnt(0)
    v_readfirstlane_b32 s1, v53
    ds_write_b32 v63, v40 offset:11840
    s_mov_b64 exec, s[36:37]
    s_nop 1
    s_cbranch_execz L_opoll_d
    s_branch L_opoll_w
L_opoll:
    buffer_load_dwordx4 v[64:67], v60, s[48:51], s70 offen offset:0 sc1
    buffer_load_dwordx4 v[68:71], v60, s[48:51], s70 offen offset:16 sc1
    buffer_load_dwordx4 v[72:75], v59, s[48:51], s70 offen offset:256 sc1
L_opoll_w:
    s_waitcnt vmcnt(0)
    v_bitop3_b32 v76, v65, v67, s76 bitop3:0x7e
    v_bitop3_b32 v77, v69, v71, s76 bitop3:0x7e
    v_bitop3_b32 v78, v73, v75, s76 bitop3:0x7e
    v_or3_b32 v76, v76, v77, v78
    v_cmp_ne_u32 vcc, 0, v76
    s_nop 0
    s_cbranch_vccz L_opoll_d
    s_mov_b64 exec, vcc
    s_sub_u32 s71, s71, 1
    s_cbranch_scc1 L_opoll_d
    s_and_b32 s0, s71, 31
    s_cbranch_scc1 L_opoll
    s_mov_b64 exec, -1
    v_lshlrev_b32 v13, 4, v1
    ds_read_b128 v[80:83], v13 offset:14400
    ds_read_b128 v[84:87], v13 offset:15424
    ds_read_b128 v[88:91], v13 offset:16448
    s_add_u32 s0, s66, 2304
    s_waitcnt lgkmcnt(0)
    buffer_store_dwordx4 v[80:83], v13, s[48:51], s0 offen offset:0 sc1
    buffer_store_dwordx4 v[84:87], v13, s[48:51], s0 offen offset:1024 sc1
    s_mov_b32 exec_lo, 0xffff
    s_mov_b32 exec_hi, 0
    buffer_store_dwordx4 v[88:91], v13, s[48:51], s0 offen offset:2048 sc1
    s_cmp_lt_u32 s75, 30
    s_cbranch_scc0 L_nop1_2
    s_mov_b64 exec, -1
    v_lshlrev_b32 v128, 4, v1
    ds_read_b128 v[120:123], v128 offset:7232
    ds_read_b128 v[124:127], v128 offset:8256
    v_lshrrev_b32 v128, 5, v1
    s_lshl_b32 s0, s75, 2
    s_add_u32 s0, s0, 0
    v_add_u32 v128, s0, v128
    v_mul_u32_u24 v129, 137, v128
    v_lshrrev_b32 v129, 11, v129
    v_mul_u32_u24 v130, 15, v129
    v_sub_u32 v128, v128, v130
    v_lshl_add_u32 v128, v128, 3, v129
    v_lshlrev_b32 v128, 9, v128
    v_and_b32 v129, 31, v1
    v_lshl_add_u32 v128, v129, 4, v128
    s_mul_i32 s0, s74, 61440
    s_add_u32 s0, s0, 1968128
    s_waitcnt lgkmcnt(0)
    buffer_store_dwordx4 v[120:123], v128, s[48:51], s0 offen sc1
    v_lshrrev_b32 v128, 5, v1
    s_lshl_b32 s0, s75, 2
    s_add_u32 s0, s0, 2
    v_add_u32 v128, s0, v128
    v_mul_u32_u24 v129, 137, v128
    v_lshrrev_b32 v129, 11, v129
    v_mul_u32_u24 v130, 15, v129
    v_sub_u32 v128, v128, v130
    v_lshl_add_u32 v128, v128, 3, v129
    v_lshlrev_b32 v128, 9, v128
    v_and_b32 v129, 31, v1
    v_lshl_add_u32 v128, v129, 4, v128
    s_mul_i32 s0, s74, 61440
    s_add_u32 s0, s0, 1968128
    s_waitcnt lgkmcnt(0)
    buffer_store_dwordx4 v[124:127], v128, s[48:51], s0 offen sc1
    s_nop 1
L_nop1_2:
    s_mov_b64 exec, vcc
    buffer_load_dwordx4 v[64:67], v60, s[48:51], s70 offen offset:2304 sc1
    buffer_load_dwordx4 v[68:71], v60, s[48:51], s70 offen offset:2320 sc1
    buffer_load_dwordx4 v[72:75], v59, s[48:51], s70 offen offset:2560 sc1
    s_branch L_opoll_w
L_opoll_d:
    s_mov_b64 exec, s[78:79]
    ds_bpermute_b32 v73, v15, v72
    ds_bpermute_b32 v75, v15, v74
    ds_bpermute_b32 v65, v15, v64
    ds_bpermute_b32 v67, v15, v66
    ds_bpermute_b32 v69, v15, v68
    ds_bpermute_b32 v71, v15, v70
    s_waitcnt lgkmcnt(5)
    v_max_f32_dpp v54, v73, v73 quad_perm:[1,0,3,2] row_mask:0xf bank_mask:0xf
    s_nop 1
    v_max_f32_dpp v54, v54, v54 quad_perm:[2,3,0,1] row_mask:0xf bank_mask:0xf
    s_nop 1
    v_max_f32_dpp v54, v54, v54 row_half_mirror row_mask:0xf bank_mask:0xf
    v_sub_f32 v52, v73, v54
    v_exp_f32 v52, v52
    s_waitcnt lgkmcnt(0)
    v_mul_f32 v53, v52, v75
    v_mul_f32 v44, v52, v65
    v_mul_f32 v45, v52, v67
    v_mul_f32 v46, v52, v69
    v_mul_f32 v47, v52, v71
    v_add_f32_dpp v53, v53, v53 quad_perm:[1,0,3,2] row_mask:0xf bank_mask:0xf
    v_add_f32_dpp v44, v44, v44 quad_perm:[1,0,3,2] row_mask:0xf bank_mask:0xf
    v_add_f32_dpp v45, v45, v45 quad_perm:[1,0,3,2] row_mask:0xf bank_mask:0xf
    v_add_f32_dpp v46, v46, v46 quad_perm:[1,0,3,2] row_mask:0xf bank_mask:0xf
    v_add_f32_dpp v47, v47, v47 quad_perm:[1,0,3,2] row_mask:0xf bank_mask:0xf
    v_add_f32_dpp v53, v53, v53 quad_perm:[2,3,0,1] row_mask:0xf bank_mask:0xf
    v_add_f32_dpp v44, v44, v44 quad_perm:[2,3,0,1] row_mask:0xf bank_mask:0xf
    v_add_f32_dpp v45, v45, v45 quad_perm:[2,3,0,1] row_mask:0xf bank_mask:0xf
    v_add_f32_dpp v46, v46, v46 quad_perm:[2,3,0,1] row_mask:0xf bank_mask:0xf
    v_add_f32_dpp v47, v47, v47 quad_perm:[2,3,0,1] row_mask:0xf bank_mask:0xf
    v_add_f32_dpp v53, v53, v53 row_half_mirror row_mask:0xf bank_mask:0xf
    v_add_f32_dpp v44, v44, v44 row_half_mirror row_mask:0xf bank_mask:0xf
    v_rcp_f32 v53, v53
    v_add_f32_dpp v45, v45, v45 row_half_mirror row_mask:0xf bank_mask:0xf
    v_add_f32_dpp v46, v46, v46 row_half_mirror row_mask:0xf bank_mask:0xf
    v_add_f32_dpp v47, v47, v47 row_half_mirror row_mask:0xf bank_mask:0xf
    v_mul_f32 v44, v53, v44
    v_mul_f32 v45, v53, v45
    v_mul_f32 v46, v53, v46
    v_mul_f32 v47, v53, v47
    v_cvt_pk_bf16_f32 v76, v44, v44
    v_cvt_pk_bf16_f32 v77, v45, v45
    v_cvt_pk_bf16_f32 v78, v46, v46
    v_cvt_pk_bf16_f32 v79, v47, v47
    v_and_b32 v80, v76, v8
    v_and_b32 v81, v76, v9
    v_and_b32 v82, v76, v10
    v_and_b32 v83, v76, v11
    v_and_b32 v84, v77, v8
    v_and_b32 v85, v77, v9
    v_and_b32 v86, v77, v10
    v_and_b32 v87, v77, v11
    v_mfma_f32_16x16x32_bf16 v[32:35], v[80:83], v[16:19], v[32:35]
    v_and_b32 v88, v78, v8
    v_and_b32 v89, v78, v9
    v_and_b32 v90, v78, v10
    v_and_b32 v91, v78, v11
    v_mfma_f32_16x16x32_bf16 v[32:35], v[84:87], v[20:23], v[32:35]
    v_and_b32 v92, v79, v8
    v_and_b32 v93, v79, v9
    v_and_b32 v94, v79, v10
    v_and_b32 v95, v79, v11
    v_mfma_f32_16x16x32_bf16 v[32:35], v[88:91], v[24:27], v[32:35]
    s_nop 0
    v_mfma_f32_16x16x32_bf16 v[32:35], v[92:95], v[28:31], v[32:35]
    s_nop 7
    v_permlane32_swap_b32 v32, v33
    v_permlane32_swap_b32 v34, v35
    s_nop 0
    v_add_f32_dpp v48, v33, v32 row_ror:8 row_mask:0xf bank_mask:0x3
    v_add_f32_dpp v48, v34, v35 row_ror:8 row_mask:0xf bank_mask:0xc
    ds_write_b32 v63, v48 offset:9280
    s_waitcnt lgkmcnt(0)
    s_barrier
    s_cmp_lt_u32 s3, 2
    s_cbranch_scc0 L_safe_end
    ds_read_b64 v[44:45], v61 offset:9280
    ds_read_b64 v[46:47], v61 offset:9600
    ds_read_b64 v[48:49], v61 offset:9920
    ds_read_b64 v[50:51], v61 offset:10240
    s_waitcnt lgkmcnt(2)
    v_add_f32 v44, v44, v46
    v_add_f32 v45, v45, v47
    s_waitcnt lgkmcnt(0)
    v_add_f32 v48, v48, v50
    v_add_f32 v49, v49, v51
    v_add_f32 v44, v44, v48
    v_add_f32 v45, v45, v49
    v_mov_b32 v46, v44
    v_mov_b32 v47, v45
    s_nop 0
    v_permlane32_swap_b32 v44, v46
    v_permlane32_swap_b32 v45, v47
    v_add_f32 v108, v44, v46
    v_add_f32 v110, v45, v47
    s_mov_b32 exec_lo, -1
    s_mov_b32 exec_hi, 0
    buffer_store_dwordx4 v[108:111], v62, s[48:51], s68 offen sc1
    s_mov_b64 exec, s[78:79]
    s_nop 0
L_safe_end:
    s_cmp_lg_u32 s1, 0
    s_cbranch_scc1 L_nosafe_end
    s_barrier
    s_mov_b64 exec, s[34:35]
    s_cbranch_execz L_nosafe_3
    buffer_store_dwordx4 v[104:107], v58, s[48:51], s66 offen offset:2304 sc1
L_nosafe_3:
    s_mov_b64 exec, s[78:79]
    s_cmp_eq_u32 s3, 6
    s_cbranch_scc0 L_nosafe_end
    s_cmp_lt_u32 s75, 30
    s_cbranch_scc0 L_nop1_4
    s_mov_b64 exec, -1
    v_lshlrev_b32 v128, 4, v1
    ds_read_b128 v[120:123], v128 offset:7232
    ds_read_b128 v[124:127], v128 offset:8256
    v_lshrrev_b32 v128, 5, v1
    s_lshl_b32 s0, s75, 2
    s_add_u32 s0, s0, 0
    v_add_u32 v128, s0, v128
    v_mul_u32_u24 v129, 137, v128
    v_lshrrev_b32 v129, 11, v129
    v_mul_u32_u24 v130, 15, v129
    v_sub_u32 v128, v128, v130
    v_lshl_add_u32 v128, v128, 3, v129
    v_lshlrev_b32 v128, 9, v128
    v_and_b32 v129, 31, v1
    v_lshl_add_u32 v128, v129, 4, v128
    s_mul_i32 s0, s74, 61440
    s_add_u32 s0, s0, 1968128
    s_waitcnt lgkmcnt(0)
    buffer_store_dwordx4 v[120:123], v128, s[48:51], s0 offen sc1
    v_lshrrev_b32 v128, 5, v1
    s_lshl_b32 s0, s75, 2
    s_add_u32 s0, s0, 2
    v_add_u32 v128, s0, v128
    v_mul_u32_u24 v129, 137, v128
    v_lshrrev_b32 v129, 11, v129
    v_mul_u32_u24 v130, 15, v129
    v_sub_u32 v128, v128, v130
    v_lshl_add_u32 v128, v128, 3, v129
    v_lshlrev_b32 v128, 9, v128
    v_and_b32 v129, 31, v1
    v_lshl_add_u32 v128, v129, 4, v128
    s_mul_i32 s0, s74, 61440
    s_add_u32 s0, s0, 1968128
    s_waitcnt lgkmcnt(0)
    buffer_store_dwordx4 v[124:127], v128, s[48:51], s0 offen sc1
    s_nop 1
L_nop1_4:
L_nosafe_end:
    s_branch L_done
L_final:
    ds_read_b32 v53, v14 offset:8
    s_waitcnt lgkmcnt(0)
    v_readfirstlane_b32 s1, v53
    s_nop 0
    s_cmp_lg_u32 s1, 0
    s_nop 1
    s_cbranch_scc1 L_final2
    s_mov_b64 exec, s[34:35]
    s_cbranch_execz L_nosafe_5
    buffer_store_dwordx4 v[104:107], v58, s[48:51], s66 offen offset:2304 sc1
L_nosafe_5:
    s_mov_b64 exec, s[78:79]
    s_nop 0
L_final2:
    s_cmp_lt_u32 s3, 5
    s_cbranch_scc0 L_done
    s_mov_b32 s60, s22
    s_mov_b32 s61, s23
    s_mov_b32 s62, 1280
    s_mov_b32 s63, 0x20000
    buffer_load_ushort v118, v117, s[60:63], 0 offen
    buffer_load_ushort v119, v117, s[44:47], 0 offen
    s_lshr_b32 s36, s101, 3
    s_mul_i32 s36, s36, 46080
    s_and_b32 s68, s101, 7
    s_lshl_b32 s68, s68, 6
    s_add_u32 s36, s36, s68
    s_add_u32 s36, s36, 4608
    s_waitcnt vmcnt(0)
    v_lshlrev_b32 v118, 16, v118
    v_lshlrev_b32 v119, 16, v119
    s_add_u32 s37, s36, 460800
    s_add_u32 s38, s36, 921600
    s_mov_b64 s[60:61], exec
    s_mov_b64 s[62:63], exec
    s_mov_b64 s[32:33], exec
    s_mov_b32 s40, s24
    s_mov_b32 s41, s25
    s_mov_b32 s42, 1280
    s_mov_b32 s43, 0x20000
    s_mov_b32 s71, 200000
L_sppoll:
    s_mov_b64 exec, s[60:61]
    s_cbranch_execz L_sk_6
    buffer_load_dwordx4 v[64:67], v116, s[48:51], s36 offen sc1
L_sk_6:
    s_mov_b64 exec, s[62:63]
    s_cbranch_execz L_sk_7
    buffer_load_dwordx4 v[68:71], v116, s[48:51], s37 offen sc1
L_sk_7:
    s_mov_b64 exec, s[32:33]
    s_cbranch_execz L_sk_8
    buffer_load_dwordx4 v[72:75], v116, s[48:51], s38 offen sc1
L_sk_8:
    s_mov_b64 exec, s[78:79]
    s_waitcnt vmcnt(0)
    v_bitop3_b32 v76, v65, v67, s76 bitop3:0x7e
    v_bitop3_b32 v77, v69, v71, s76 bitop3:0x7e
    v_bitop3_b32 v78, v73, v75, s76 bitop3:0x7e
    v_or3_b32 v79, v76, v77, v78
    v_cmp_ne_u32 vcc, 0, v79
    s_nop 0
    s_cbranch_vccz L_spd
    v_cmp_ne_u32 s[60:61], 0, v76
    v_cmp_ne_u32 s[62:63], 0, v77
    v_cmp_ne_u32 s[32:33], 0, v78
    s_sub_u32 s71, s71, 1
    s_cbranch_scc0 L_sppoll
L_spd:
    v_add_f32 v64, v64, v68
    v_add_f32 v66, v66, v70
    v_add_f32 v64, v64, v72
    v_add_f32 v66, v66, v74
    s_nop 1
    v_permlane32_swap_b32 v64, v66
    v_add_f32 v64, v64, v66
    s_nop 1
    v_add_f32_dpp v64, v64, v64 row_ror:8 row_mask:0xf bank_mask:0xf
    v_mov_b32 v66, v64
    s_nop 1
    v_permlane16_swap_b32 v64, v66
    v_add_f32 v64, v64, v66
    v_cvt_pk_bf16_f32 v27, v64, v64
    v_and_b32 v27, 0xffff0000, v27
    v_add_f32 v26, v27, v118
    v_cvt_pk_bf16_f32 v26, v26, v26
    v_and_b32 v26, 0xffff0000, v26
    v_mul_f32 v28, 0xbfb8aa3b, v26
    v_exp_f32 v28, v28
    s_nop 0
    v_add_f32 v28, 1.0, v28
    v_rcp_f32 v28, v28
    s_nop 0
    v_mul_f32 v26, v26, v28
    v_cvt_pk_bf16_f32 v26, v26, v26
    v_and_b32 v26, 0xffff0000, v26
    s_nop 1
    v_mul_f32_dpp v27, v26, v27 row_half_mirror row_mask:0xf bank_mask:0xf
    v_cvt_pk_bf16_f32 v27, v27, v27
    v_and_b32 v27, 0xffff0000, v27
    v_add_f32 v27, v27, v119
    v_cvt_pk_bf16_f32 v27, v27, v27
    s_mov_b32 exec_lo, 0xf
    s_mov_b32 exec_hi, 0xf
    buffer_store_short v27, v117, s[40:43], 0 offen
    s_cmp_eq_u32 s101, 0
    s_cbranch_scc0 L_done
    s_mov_b32 exec_lo, 1
    s_mov_b32 exec_hi, 0
    s_mov_b32 s68, 2459648
    buffer_store_dword v105, v2, s[48:51], s68 offen
L_done:
L_end:
    s_endpgm
L_codeend:
.section .rodata,"a"
.p2align 6
.amdhsa_kernel recurrent_scan__sliding_block_cached__dense_activation_squared_relu__decode_kernel
  .amdhsa_next_free_vgpr 256
  .amdhsa_next_free_sgpr 102
  .amdhsa_accum_offset 256
  .amdhsa_group_segment_fixed_size 0
  .amdhsa_kernarg_size 104
  .amdhsa_user_sgpr_count 2
  .amdhsa_user_sgpr_kernarg_segment_ptr 1
  .amdhsa_system_sgpr_workgroup_id_x 1
  .amdhsa_float_denorm_mode_32 3
.end_amdhsa_kernel
```
